```python
import torch

def _softmax(x, axis=-1):
    return torch.softmax(x, dim=axis)
def _gelu(x):
    return torch.nn.functional.gelu(x, approximate="tanh")
def _silu(x):
    return torch.nn.functional.silu(x)
def _sigmoid(x):
    return torch.sigmoid(x)
def _layernorm(x, axis=-1, eps=1e-5):
    m = x.mean(dim=axis, keepdim=True)
    v = x.var(dim=axis, keepdim=True, unbiased=False)
    return (x - m) / torch.sqrt(v + eps)
def _scatter_add(tgt, idx, src, axis=0):
    return tgt.clone().index_add_(axis, idx, src)
def _segment_sum(src, seg, n):
    out = torch.zeros((n,) + src.shape[1:], dtype=src.dtype)
    return out.index_add_(0, seg, src)
def _pad(x, pw):
    flat = tuple(v for pair in reversed(pw) for v in pair)
    return torch.nn.functional.pad(x, flat)

kernel_name = 'standalone__groupnorm__sampling'

def setup_inputs():

    _w = (lambda a: (lambda t: t.to(torch.bfloat16) if t.is_floating_point() else t)(torch.as_tensor(a)))
    B = 32
    G = 32
    cpg = max(1, 576 // G)
    C = G * cpg
    H, W = 32, 16
    return {
        "x": _w(abs((lambda *s: torch.randn(*s, dtype=torch.bfloat16) * 0.05)(B, C, H, W))),
        "g": _w((lambda *s: torch.randn(*s, dtype=torch.bfloat16) * 0.05)(C) + 1.0),
        "b": _w((lambda *s: torch.randn(*s, dtype=torch.bfloat16) * 0.4)(C)),
    }

def reference(x, g, b):
    G = 32
    B, C, H, W = x.shape[0], x.shape[1], x.shape[2], x.shape[3]
    xr = x.reshape(B, G, C // G, H, W)
    mu = xr.mean(axis=(2, 3, 4), keepdims=True)
    var = ((xr - mu) ** 2).mean(axis=(2, 3, 4), keepdims=True)
    xn = (xr - mu) / torch.sqrt(var + 1e-5)
    xn = xn.reshape(B, C, H, W)
    return xn * g[None, :, None, None] + b[None, :, None, None]
```

```asm
; @launch grid=(512,1,1) block=(384,1,1) lds=48
.amdgcn_target "amdgcn-amd-amdhsa--gfx950"
.text
.globl standalone__groupnorm__sampling_kernel
.p2align 8
.type standalone__groupnorm__sampling_kernel,@function
standalone__groupnorm__sampling_kernel:
    s_load_dwordx8 s[4:11], s[0:1], 0
    s_cmp_ge_u32 s2, 512
    s_cbranch_scc1 L_end
    s_mul_i32 s12, s2, 36864
    v_lshrrev_b32 v3, 6, v0
    v_lshl_add_u32 v1, v0, 4, s12
    s_movk_i32 s13, 5120
    v_mad_u32_u24 v1, v3, s13, v1
    v_readfirstlane_b32 s3, v3
    v_and_b32 v0, 63, v0
    v_and_b32 v3, 3, v0
    v_lshlrev_b32 v3, 4, v3
    v_mov_b32 v4, 0x3f80
    v_mov_b32 v5, 0
    v_lshlrev_b64 v[4:5], v3, v[4:5]
    s_mul_i32 s17, s3, 86
    s_lshr_b32 s17, s17, 8
    s_mul_i32 s18, s17, 18432
    s_add_u32 s18, s18, s12
    s_and_b32 s14, s2, 15
    s_mul_i32 s14, s14, 36
    s_mul_i32 s15, s3, 6
    s_add_u32 s14, s14, s15
    v_min_u32 v3, 5, v0
    v_add_lshl_u32 v3, v3, s14, 1
    v_mov_b32 v6, 0
    v_mov_b32 v7, 0
    s_waitcnt lgkmcnt(0)
    s_load_dword s16, s[4:5], s18
    global_load_dwordx4 v[16:19], v1, s[4:5] offset:0 nt
    global_load_dwordx4 v[20:23], v1, s[4:5] offset:1024 nt
    global_load_dwordx4 v[24:27], v1, s[4:5] offset:2048 nt
    global_load_dwordx4 v[28:31], v1, s[4:5] offset:3072 nt
    v_add_u32 v2, 8192, v1
    global_load_dwordx4 v[32:35], v2, s[4:5] offset:-4096 nt
    global_load_dwordx4 v[36:39], v2, s[4:5] offset:-3072 nt
    global_load_short_d16_hi v6, v3, s[6:7]
    global_load_short_d16_hi v7, v3, s[8:9]
    s_mov_b32 s22, 0x38e38e39
    s_lshl_b32 s23, s3, 3
    s_mul_i32 s21, s17, 24
    v_mov_b32 v3, s23
    v_mov_b32 v0, s21
    s_waitcnt lgkmcnt(0)
    s_lshl_b32 s16, s16, 16
    s_xor_b32 s16, s16, 0x80000000
    v_mov_b32 v8, s16
    v_mov_b32 v9, s16
    v_mov_b32 v10, s16
    v_mov_b32 v11, s16
    s_nop 0
    s_waitcnt vmcnt(7)
    v_mfma_f32_4x4x4_16b_bf16 v[40:43], v[4:5], v[16:17], v[8:11]
    v_mfma_f32_4x4x4_16b_bf16 v[44:47], v[4:5], v[18:19], v[8:11]
    s_waitcnt vmcnt(6)
    v_mfma_f32_4x4x4_16b_bf16 v[48:51], v[4:5], v[20:21], v[8:11]
    v_mfma_f32_4x4x4_16b_bf16 v[52:55], v[4:5], v[22:23], v[8:11]
    s_nop 0
    v_pk_mul_f32 v[14:15], v[40:41], v[40:41]
    v_pk_add_f32 v[12:13], v[40:41], v[42:43]
    v_pk_fma_f32 v[14:15], v[42:43], v[42:43], v[14:15]
    v_pk_add_f32 v[12:13], v[12:13], v[44:45]
    v_pk_fma_f32 v[14:15], v[44:45], v[44:45], v[14:15]
    v_pk_add_f32 v[12:13], v[12:13], v[46:47]
    v_pk_fma_f32 v[14:15], v[46:47], v[46:47], v[14:15]
    s_waitcnt vmcnt(5)
    v_mfma_f32_4x4x4_16b_bf16 v[56:59], v[4:5], v[24:25], v[8:11]
    v_mfma_f32_4x4x4_16b_bf16 v[60:63], v[4:5], v[26:27], v[8:11]
    v_pk_add_f32 v[12:13], v[12:13], v[48:49]
    v_pk_fma_f32 v[14:15], v[48:49], v[48:49], v[14:15]
    v_pk_add_f32 v[12:13], v[12:13], v[50:51]
    v_pk_fma_f32 v[14:15], v[50:51], v[50:51], v[14:15]
    v_pk_add_f32 v[12:13], v[12:13], v[52:53]
    v_pk_fma_f32 v[14:15], v[52:53], v[52:53], v[14:15]
    v_pk_add_f32 v[12:13], v[12:13], v[54:55]
    v_pk_fma_f32 v[14:15], v[54:55], v[54:55], v[14:15]
    s_waitcnt vmcnt(4)
    v_mfma_f32_4x4x4_16b_bf16 v[64:67], v[4:5], v[28:29], v[8:11]
    v_mfma_f32_4x4x4_16b_bf16 v[68:71], v[4:5], v[30:31], v[8:11]
    v_pk_add_f32 v[12:13], v[12:13], v[56:57]
    v_pk_fma_f32 v[14:15], v[56:57], v[56:57], v[14:15]
    v_pk_add_f32 v[12:13], v[12:13], v[58:59]
    v_pk_fma_f32 v[14:15], v[58:59], v[58:59], v[14:15]
    v_pk_add_f32 v[12:13], v[12:13], v[60:61]
    v_pk_fma_f32 v[14:15], v[60:61], v[60:61], v[14:15]
    v_pk_add_f32 v[12:13], v[12:13], v[62:63]
    v_pk_fma_f32 v[14:15], v[62:63], v[62:63], v[14:15]
    s_waitcnt vmcnt(3)
    v_mfma_f32_4x4x4_16b_bf16 v[72:75], v[4:5], v[32:33], v[8:11]
    v_mfma_f32_4x4x4_16b_bf16 v[76:79], v[4:5], v[34:35], v[8:11]
    v_pk_add_f32 v[12:13], v[12:13], v[64:65]
    v_pk_fma_f32 v[14:15], v[64:65], v[64:65], v[14:15]
    v_pk_add_f32 v[12:13], v[12:13], v[66:67]
    v_pk_fma_f32 v[14:15], v[66:67], v[66:67], v[14:15]
    v_pk_add_f32 v[12:13], v[12:13], v[68:69]
    v_pk_fma_f32 v[14:15], v[68:69], v[68:69], v[14:15]
    v_pk_add_f32 v[12:13], v[12:13], v[70:71]
    v_pk_fma_f32 v[14:15], v[70:71], v[70:71], v[14:15]
    s_waitcnt vmcnt(2)
    v_mfma_f32_4x4x4_16b_bf16 v[80:83], v[4:5], v[36:37], v[8:11]
    v_mfma_f32_4x4x4_16b_bf16 v[84:87], v[4:5], v[38:39], v[8:11]
    v_pk_add_f32 v[12:13], v[12:13], v[72:73]
    v_pk_fma_f32 v[14:15], v[72:73], v[72:73], v[14:15]
    v_pk_add_f32 v[12:13], v[12:13], v[74:75]
    v_pk_fma_f32 v[14:15], v[74:75], v[74:75], v[14:15]
    v_pk_add_f32 v[12:13], v[12:13], v[76:77]
    v_pk_fma_f32 v[14:15], v[76:77], v[76:77], v[14:15]
    v_pk_add_f32 v[12:13], v[12:13], v[78:79]
    v_pk_fma_f32 v[14:15], v[78:79], v[78:79], v[14:15]
    v_pk_add_f32 v[12:13], v[12:13], v[80:81]
    v_pk_fma_f32 v[14:15], v[80:81], v[80:81], v[14:15]
    v_pk_add_f32 v[12:13], v[12:13], v[82:83]
    v_pk_fma_f32 v[14:15], v[82:83], v[82:83], v[14:15]
    v_pk_add_f32 v[12:13], v[12:13], v[84:85]
    v_pk_fma_f32 v[14:15], v[84:85], v[84:85], v[14:15]
    v_pk_add_f32 v[12:13], v[12:13], v[86:87]
    v_pk_fma_f32 v[14:15], v[86:87], v[86:87], v[14:15]
    v_add_f32 v12, v12, v13
    v_add_f32 v13, v14, v15
    v_mov_b32 v15, 0x3727c5ac
    v_add_f32_dpp v12, v12, v12 quad_perm:[1,0,3,2] row_mask:0xf bank_mask:0xf
    v_add_f32_dpp v13, v13, v13 quad_perm:[1,0,3,2] row_mask:0xf bank_mask:0xf
    s_nop 0
    v_add_f32_dpp v12, v12, v12 quad_perm:[2,3,0,1] row_mask:0xf bank_mask:0xf
    v_add_f32_dpp v13, v13, v13 quad_perm:[2,3,0,1] row_mask:0xf bank_mask:0xf
    s_nop 0
    v_add_f32_dpp v12, v12, v12 row_half_mirror row_mask:0xf bank_mask:0xf
    v_add_f32_dpp v13, v13, v13 row_half_mirror row_mask:0xf bank_mask:0xf
    s_nop 0
    v_add_f32_dpp v12, v12, v12 row_mirror row_mask:0xf bank_mask:0xf
    v_add_f32_dpp v13, v13, v13 row_mirror row_mask:0xf bank_mask:0xf
    s_nop 0
    v_add_f32_dpp v12, v12, v12 row_bcast:15 row_mask:0xa bank_mask:0xf
    v_add_f32_dpp v13, v13, v13 row_bcast:15 row_mask:0xa bank_mask:0xf
    s_nop 0
    v_add_f32_dpp v12, v12, v12 row_bcast:31 row_mask:0xc bank_mask:0xf
    v_add_f32_dpp v13, v13, v13 row_bcast:31 row_mask:0xc bank_mask:0xf
    s_mov_b32 exec_lo, 0
    s_brev_b32 exec_hi, 1
    ds_write_b64 v3, v[12:13]
    s_mov_b64 exec, -1
    s_waitcnt lgkmcnt(0)
    s_barrier
    ds_read2_b64 v[88:91], v0 offset1:1
    ds_read_b64 v[92:93], v0 offset:16
    s_waitcnt lgkmcnt(0)
    v_pk_add_f32 v[88:89], v[88:89], v[90:91]
    v_pk_add_f32 v[88:89], v[88:89], v[92:93]
    v_mul_f32 v13, s22, v88
    v_mul_f32 v14, s22, v89
    v_sub_f32 v12, v13, v8
    v_fma_f32 v14, -v13, v13, v14
    v_cvt_pk_bf16_f32 v12, v12, v12
    v_max_f32 v14, 0, v14
    v_lshlrev_b32 v12, 16, v12
    v_add_f32 v12, v12, v8
    v_sub_f32 v13, v13, v12
    v_fma_f32 v14, v13, v13, v14
    v_cvt_pk_bf16_f32 v14, v14, v14
    v_lshlrev_b32 v14, 16, v14
    v_add_f32 v14, v14, v15
    v_cvt_pk_bf16_f32 v14, v14, v14
    v_lshlrev_b32 v14, 16, v14
    v_sqrt_f32 v14, v14
    s_nop 0
    v_cvt_pk_bf16_f32 v14, v14, v14
    v_lshlrev_b32 v14, 16, v14
    v_rcp_f32 v14, v14
    s_waitcnt vmcnt(0)
    v_mul_f32 v6, v6, v14
    v_fma_f32 v7, -v12, v6, v7
    v_readlane_b32 s28, v6, 0
    v_readlane_b32 s29, v7, 0
    v_readlane_b32 s30, v6, 1
    v_readlane_b32 s31, v7, 1
    v_pk_fma_f32 v[40:41], v[40:41], s[28:29], s[28:29] op_sel:[0,0,1] op_sel_hi:[1,0,1]
    v_pk_fma_f32 v[42:43], v[42:43], s[28:29], s[28:29] op_sel:[0,0,1] op_sel_hi:[1,0,1]
    v_pk_fma_f32 v[44:45], v[44:45], s[28:29], s[28:29] op_sel:[0,0,1] op_sel_hi:[1,0,1]
    v_pk_fma_f32 v[46:47], v[46:47], s[28:29], s[28:29] op_sel:[0,0,1] op_sel_hi:[1,0,1]
    v_cvt_pk_bf16_f32 v16, v40, v41
    v_cvt_pk_bf16_f32 v17, v42, v43
    v_cvt_pk_bf16_f32 v18, v44, v45
    v_cvt_pk_bf16_f32 v19, v46, v47
    global_store_dwordx4 v1, v[16:19], s[10:11] offset:0 nt
    v_readlane_b32 s28, v6, 2
    v_readlane_b32 s29, v7, 2
    v_pk_fma_f32 v[48:49], v[48:49], s[30:31], s[30:31] op_sel:[0,0,1] op_sel_hi:[1,0,1]
    v_pk_fma_f32 v[50:51], v[50:51], s[30:31], s[30:31] op_sel:[0,0,1] op_sel_hi:[1,0,1]
    v_pk_fma_f32 v[52:53], v[52:53], s[30:31], s[30:31] op_sel:[0,0,1] op_sel_hi:[1,0,1]
    v_pk_fma_f32 v[54:55], v[54:55], s[30:31], s[30:31] op_sel:[0,0,1] op_sel_hi:[1,0,1]
    v_cvt_pk_bf16_f32 v20, v48, v49
    v_cvt_pk_bf16_f32 v21, v50, v51
    v_cvt_pk_bf16_f32 v22, v52, v53
    v_cvt_pk_bf16_f32 v23, v54, v55
    global_store_dwordx4 v1, v[20:23], s[10:11] offset:1024 nt
    v_readlane_b32 s30, v6, 3
    v_readlane_b32 s31, v7, 3
    v_pk_fma_f32 v[56:57], v[56:57], s[28:29], s[28:29] op_sel:[0,0,1] op_sel_hi:[1,0,1]
    v_pk_fma_f32 v[58:59], v[58:59], s[28:29], s[28:29] op_sel:[0,0,1] op_sel_hi:[1,0,1]
    v_pk_fma_f32 v[60:61], v[60:61], s[28:29], s[28:29] op_sel:[0,0,1] op_sel_hi:[1,0,1]
    v_pk_fma_f32 v[62:63], v[62:63], s[28:29], s[28:29] op_sel:[0,0,1] op_sel_hi:[1,0,1]
    v_cvt_pk_bf16_f32 v24, v56, v57
    v_cvt_pk_bf16_f32 v25, v58, v59
    v_cvt_pk_bf16_f32 v26, v60, v61
    v_cvt_pk_bf16_f32 v27, v62, v63
    global_store_dwordx4 v1, v[24:27], s[10:11] offset:2048 nt
    v_readlane_b32 s28, v6, 4
    v_readlane_b32 s29, v7, 4
    v_pk_fma_f32 v[64:65], v[64:65], s[30:31], s[30:31] op_sel:[0,0,1] op_sel_hi:[1,0,1]
    v_pk_fma_f32 v[66:67], v[66:67], s[30:31], s[30:31] op_sel:[0,0,1] op_sel_hi:[1,0,1]
    v_pk_fma_f32 v[68:69], v[68:69], s[30:31], s[30:31] op_sel:[0,0,1] op_sel_hi:[1,0,1]
    v_pk_fma_f32 v[70:71], v[70:71], s[30:31], s[30:31] op_sel:[0,0,1] op_sel_hi:[1,0,1]
    v_cvt_pk_bf16_f32 v28, v64, v65
    v_cvt_pk_bf16_f32 v29, v66, v67
    v_cvt_pk_bf16_f32 v30, v68, v69
    v_cvt_pk_bf16_f32 v31, v70, v71
    global_store_dwordx4 v1, v[28:31], s[10:11] offset:3072 nt
    v_readlane_b32 s30, v6, 5
    v_readlane_b32 s31, v7, 5
    v_pk_fma_f32 v[72:73], v[72:73], s[28:29], s[28:29] op_sel:[0,0,1] op_sel_hi:[1,0,1]
    v_pk_fma_f32 v[74:75], v[74:75], s[28:29], s[28:29] op_sel:[0,0,1] op_sel_hi:[1,0,1]
    v_pk_fma_f32 v[76:77], v[76:77], s[28:29], s[28:29] op_sel:[0,0,1] op_sel_hi:[1,0,1]
    v_pk_fma_f32 v[78:79], v[78:79], s[28:29], s[28:29] op_sel:[0,0,1] op_sel_hi:[1,0,1]
    v_cvt_pk_bf16_f32 v32, v72, v73
    v_cvt_pk_bf16_f32 v33, v74, v75
    v_cvt_pk_bf16_f32 v34, v76, v77
    v_cvt_pk_bf16_f32 v35, v78, v79
    global_store_dwordx4 v2, v[32:35], s[10:11] offset:-4096 nt
    v_pk_fma_f32 v[80:81], v[80:81], s[30:31], s[30:31] op_sel:[0,0,1] op_sel_hi:[1,0,1]
    v_pk_fma_f32 v[82:83], v[82:83], s[30:31], s[30:31] op_sel:[0,0,1] op_sel_hi:[1,0,1]
    v_pk_fma_f32 v[84:85], v[84:85], s[30:31], s[30:31] op_sel:[0,0,1] op_sel_hi:[1,0,1]
    v_pk_fma_f32 v[86:87], v[86:87], s[30:31], s[30:31] op_sel:[0,0,1] op_sel_hi:[1,0,1]
    v_cvt_pk_bf16_f32 v36, v80, v81
    v_cvt_pk_bf16_f32 v37, v82, v83
    v_cvt_pk_bf16_f32 v38, v84, v85
    v_cvt_pk_bf16_f32 v39, v86, v87
    global_store_dwordx4 v2, v[36:39], s[10:11] offset:-3072 nt
L_end:
    s_endpgm
.section .rodata,"a"
.p2align 6
.amdhsa_kernel standalone__groupnorm__sampling_kernel
  .amdhsa_next_free_vgpr 94
  .amdhsa_next_free_sgpr 32
  .amdhsa_accum_offset 96
  .amdhsa_group_segment_fixed_size 0
  .amdhsa_kernarg_size 48
  .amdhsa_user_sgpr_count 2
  .amdhsa_user_sgpr_kernarg_segment_ptr 1
  .amdhsa_system_sgpr_workgroup_id_x 1
  .amdhsa_float_denorm_mode_32 3
.end_amdhsa_kernel
```
